```python
import torch

def _softmax(x, axis=-1):
    return torch.softmax(x, dim=axis)
def _gelu(x):
    return torch.nn.functional.gelu(x, approximate="tanh")
def _silu(x):
    return torch.nn.functional.silu(x)
def _sigmoid(x):
    return torch.sigmoid(x)
def _layernorm(x, axis=-1, eps=1e-5):
    m = x.mean(dim=axis, keepdim=True)
    v = x.var(dim=axis, keepdim=True, unbiased=False)
    return (x - m) / torch.sqrt(v + eps)
def _scatter_add(tgt, idx, src, axis=0):
    return tgt.clone().index_add_(axis, idx, src)
def _segment_sum(src, seg, n):
    out = torch.zeros((n,) + src.shape[1:], dtype=src.dtype)
    return out.index_add_(0, seg, src)
def _pad(x, pw):
    flat = tuple(v for pair in reversed(pw) for v in pair)
    return torch.nn.functional.pad(x, flat)

kernel_name = 'standalone__paged_block_table_kv_pagedattention__decode'

def setup_inputs():

    _w = (lambda a: (lambda t: t.to(torch.bfloat16) if t.is_floating_point() else t)(torch.as_tensor(a)))
    B, Hq, Hkv, Sq, Skv, D = 2, 32, 32, 1, 8192, 128
    bs = 16
    nbps = max(1, Skv // bs)
    num_phys = B * nbps + 4
    bt = torch.randperm(num_phys)[: B * nbps].reshape(B, nbps).to(torch.int64)
    cl = (nbps * bs - (torch.arange(1, B + 1, dtype=torch.int64) * 2654435761) % max(1, nbps * bs // 2)).to(torch.int64)
    return {
        "q": _w((lambda *s: torch.randn(*s, dtype=torch.bfloat16) * 0.8)(B, Hq, Sq, D)),
        "k_cache": _w((lambda *s: torch.randn(*s, dtype=torch.bfloat16) * 0.8)(num_phys, bs, Hkv, D)),
        "v_cache": _w((lambda *s: torch.randn(*s, dtype=torch.bfloat16) * 0.05)(num_phys, bs, Hkv, D)),
        "block_table": _w(bt),
        "context_lens": _w(cl),
    }

def reference(q, k_cache, v_cache, block_table, context_lens):
    B, Hq, Sq, D = q.shape
    bs = k_cache.shape[1]
    Hkv = k_cache.shape[2]
    nbps = block_table.shape[1]
    Skv = nbps * bs
    bt = block_table.reshape(-1)
    k = (lambda x, *d: x.permute(*d))(k_cache[bt].reshape(B, Skv, Hkv, D), 0, 2, 1, 3)
    v = (lambda x, *d: x.permute(*d))(v_cache[bt].reshape(B, Skv, Hkv, D), 0, 2, 1, 3)
    g = Hq // Hkv
    qg = q.reshape(B, Hkv, g, Sq, D)
    scores = torch.einsum("bhgqd,bhkd->bhgqk", qg, k) * (D ** -0.5)
    pos = torch.arange(Skv)
    msk = pos[None, :] < context_lens[:, None]
    scores = torch.where(msk[:, None, None, None, :], scores, -1e9)
    p = _softmax(scores, axis=-1)
    out = torch.einsum("bhgqk,bhkd->bhgqd", p, v)
    return out.reshape(B, Hq, Sq, D)
```

```asm
; @launch kernel=pa_part_kernel grid=(256,1,1) block=(1024,1,1) lds=37696
; @launch kernel=pa_comb_kernel grid=(256,1,1) block=(128,1,1) lds=0
.amdgcn_target "amdgcn-amd-amdhsa--gfx950"
.text
.globl pa_part_kernel
.p2align 8
.type pa_part_kernel,@function
pa_part_kernel:
  s_cmp_ge_u32 s2, 256
  s_cbranch_scc1 L_part_end
  s_load_dwordx16 s[16:31], s[0:1], 0
  v_lshrrev_b32 v9, 6, v0
  v_and_b32 v1, 63, v0
  v_lshlrev_b32 v10, 2, v0
  v_readfirstlane_b32 s64, v9
  s_and_b32 s65, s2, 7
  s_lshr_b32 s66, s2, 3
  s_lshl_b32 s75, s65, 10
  v_lshl_add_u32 v11, v1, 4, s75
  v_add_u32 v9, 0x2000, v11
  s_waitcnt lgkmcnt(0)
  s_load_dwordx2 s[40:41], s[24:25], 0
  global_load_dword v3, v10, s[22:23]
  global_load_dwordx4 v[12:15], v11, s[16:17]
  global_load_dwordx4 v[16:19], v9, s[16:17]
  s_mov_b32 s32, s18
  s_and_b32 s33, s19, 0xffff
  s_mov_b32 s34, 134742016
  s_mov_b32 s35, 0x00020000
  s_mov_b32 s36, s20
  s_and_b32 s37, s21, 0xffff
  s_mov_b32 s38, 134742016
  s_mov_b32 s39, 0x00020000
  s_mov_b32 s74, 0xffff0000
  s_lshl_b32 s75, s64, 13
  v_add_u32 v2, s75, v11
  v_mov_b32 v4, 0xf149f2ca
  v_mov_b32 v5, 0
  v_mov_b32 v20, 0
  v_mov_b32 v21, 0
  v_mov_b32 v22, 0
  v_mov_b32 v23, 0
  v_mov_b32 v24, 0
  v_mov_b32 v25, 0
  v_mov_b32 v26, 0
  v_mov_b32 v27, 0
  s_waitcnt lgkmcnt(0)
  s_cmp_gt_i32 s40, 0
  s_cselect_b32 s42, s40, 8192
  s_cselect_b32 s44, 0x3e0293ee, 0
  s_min_u32 s42, s42, 8192
  s_cmp_gt_i32 s41, 0
  s_cselect_b32 s43, s41, 8192
  s_cselect_b32 s45, 0x3e0293ee, 0
  s_min_u32 s43, s43, 8192
  s_add_u32 s75, s42, s43
  s_lshl_b32 s76, s42, 5
  v_cvt_f32_u32 v9, s75
  v_cvt_f32_u32 v11, s76
  v_rcp_f32 v9, v9
  s_nop 0
  v_fma_f32 v9, v9, v11, 0.5
  v_cvt_u32_f32 v9, v9
  s_nop 0
  v_readfirstlane_b32 s79, v9
  s_nop 3
  s_max_u32 s79, s79, 1
  s_min_u32 s79, s79, 31
  s_sub_u32 s75, 32, s79
  s_sub_u32 s76, s66, s79
  s_cmp_ge_u32 s66, s79
  s_cselect_b32 s67, 1, 0
  s_cselect_b32 s80, s76, s66
  s_cselect_b32 s83, s75, s79
  s_cselect_b32 s68, s43, s42
  s_cselect_b32 s78, s45, s44
  v_cvt_f32_u32 v9, s83
  v_cvt_f32_u32 v11, s68
  v_rcp_f32 v9, v9
  s_nop 0
  v_mul_f32 v9, v9, v11
  v_cvt_u32_f32 v9, v9
  s_nop 0
  v_readfirstlane_b32 s82, v9
  s_nop 3
  s_max_u32 s82, s82, 1
  s_sub_u32 s82, s82, 1
  s_mul_i32 s75, s82, s83
  s_cmp_lt_u32 s75, s68
  s_addc_u32 s82, s82, 0
  s_mul_i32 s75, s82, s83
  s_cmp_lt_u32 s75, s68
  s_addc_u32 s82, s82, 0
  s_mul_i32 s75, s82, s83
  s_cmp_lt_u32 s75, s68
  s_addc_u32 s82, s82, 0
  s_mul_i32 s46, s80, s82
  s_add_u32 s47, s46, s82
  s_min_u32 s47, s47, s68
  s_min_u32 s46, s46, s68
  s_sub_u32 s75, 15, s64
  s_add_u32 s77, s46, s75
  s_lshr_b32 s77, s77, 4
  s_add_u32 s76, s47, s75
  s_lshr_b32 s76, s76, 4
  s_sub_u32 s69, s76, s77
  s_add_u32 s70, s69, 7
  s_lshr_b32 s70, s70, 3
  v_mov_b32 v6, s78
  s_lshl_b32 s75, s67, 9
  s_add_u32 s75, s75, s77
  v_add_u32 v9, s75, v1
  v_min_u32 v9, 1023, v9
  v_lshlrev_b32 v9, 2, v9
  s_waitcnt vmcnt(2)
  ds_write_b32 v10, v3
  s_waitcnt lgkmcnt(0)
  s_barrier
  ds_read_b32 v3, v9
  v_cmp_gt_u32 vcc, s69, v1
  v_mov_b32 v10, 0xf0000000
  s_waitcnt lgkmcnt(0)
  v_lshlrev_b32 v3, 17, v3
  v_cndmask_b32 v3, v10, v3, vcc
  s_waitcnt vmcnt(0)
  s_cmp_eq_u32 s67, 0
  s_cbranch_scc1 L_qsel
  v_mov_b32 v12, v16
  v_mov_b32 v13, v17
  v_mov_b32 v14, v18
  v_mov_b32 v15, v19
L_qsel:
  s_cmp_eq_u32 s70, 0
  s_cbranch_scc1 L_loop_done
  v_readlane_b32 s48, v3, 0
  v_readlane_b32 s49, v3, 1
  v_readlane_b32 s50, v3, 2
  v_readlane_b32 s51, v3, 3
  v_readlane_b32 s52, v3, 4
  v_readlane_b32 s53, v3, 5
  v_readlane_b32 s54, v3, 6
  v_readlane_b32 s55, v3, 7
  s_nop 4
  buffer_load_dwordx4 v[36:39], v2, s[32:35], s48 offen nt
  buffer_load_dwordx4 v[40:43], v2, s[32:35], s49 offen nt
  buffer_load_dwordx4 v[44:47], v2, s[32:35], s50 offen nt
  buffer_load_dwordx4 v[48:51], v2, s[32:35], s51 offen nt
  buffer_load_dwordx4 v[52:55], v2, s[32:35], s52 offen nt
  buffer_load_dwordx4 v[56:59], v2, s[32:35], s53 offen nt
  buffer_load_dwordx4 v[60:63], v2, s[32:35], s54 offen nt
  buffer_load_dwordx4 v[64:67], v2, s[32:35], s55 offen nt
  buffer_load_dwordx4 v[68:71], v2, s[36:39], s48 offen nt
  buffer_load_dwordx4 v[72:75], v2, s[36:39], s49 offen nt
  buffer_load_dwordx4 v[76:79], v2, s[36:39], s50 offen nt
  buffer_load_dwordx4 v[80:83], v2, s[36:39], s51 offen nt
  buffer_load_dwordx4 v[84:87], v2, s[36:39], s52 offen nt
  buffer_load_dwordx4 v[88:91], v2, s[36:39], s53 offen nt
  buffer_load_dwordx4 v[92:95], v2, s[36:39], s54 offen nt
  buffer_load_dwordx4 v[96:99], v2, s[36:39], s55 offen nt
  s_mov_b32 s71, 0
  s_mov_b32 s72, s69
  s_mov_b32 s73, 8
L_loop:
  v_readlane_b32 s48, v3, s73
  s_add_u32 s73, s73, 1
  v_readlane_b32 s49, v3, s73
  s_add_u32 s73, s73, 1
  v_readlane_b32 s50, v3, s73
  s_add_u32 s73, s73, 1
  v_readlane_b32 s51, v3, s73
  s_add_u32 s73, s73, 1
  v_readlane_b32 s52, v3, s73
  s_add_u32 s73, s73, 1
  v_readlane_b32 s53, v3, s73
  s_add_u32 s73, s73, 1
  v_readlane_b32 s54, v3, s73
  s_add_u32 s73, s73, 1
  v_readlane_b32 s55, v3, s73
  s_add_u32 s73, s73, 1
  s_cmp_gt_i32 s72, 0
  s_cselect_b32 s56, 0, 0xf149f2ca
  s_cmp_gt_i32 s72, 1
  s_cselect_b32 s57, 0, 0xf149f2ca
  s_cmp_gt_i32 s72, 2
  s_cselect_b32 s58, 0, 0xf149f2ca
  s_cmp_gt_i32 s72, 3
  s_cselect_b32 s59, 0, 0xf149f2ca
  s_cmp_gt_i32 s72, 4
  s_cselect_b32 s60, 0, 0xf149f2ca
  s_cmp_gt_i32 s72, 5
  s_cselect_b32 s61, 0, 0xf149f2ca
  s_cmp_gt_i32 s72, 6
  s_cselect_b32 s62, 0, 0xf149f2ca
  s_cmp_gt_i32 s72, 7
  s_cselect_b32 s63, 0, 0xf149f2ca
  s_waitcnt vmcnt(8)
  v_dot2_f32_bf16 v28, v36, v12, 0
  v_dot2_f32_bf16 v29, v40, v12, 0
  v_dot2_f32_bf16 v30, v44, v12, 0
  v_dot2_f32_bf16 v31, v48, v12, 0
  v_dot2_f32_bf16 v32, v52, v12, 0
  v_dot2_f32_bf16 v33, v56, v12, 0
  v_dot2_f32_bf16 v34, v60, v12, 0
  v_dot2_f32_bf16 v35, v64, v12, 0
  v_dot2c_f32_bf16 v28, v37, v13
  v_dot2c_f32_bf16 v29, v41, v13
  v_dot2c_f32_bf16 v30, v45, v13
  v_dot2c_f32_bf16 v31, v49, v13
  v_dot2c_f32_bf16 v32, v53, v13
  v_dot2c_f32_bf16 v33, v57, v13
  v_dot2c_f32_bf16 v34, v61, v13
  v_dot2c_f32_bf16 v35, v65, v13
  v_dot2c_f32_bf16 v28, v38, v14
  v_dot2c_f32_bf16 v29, v42, v14
  v_dot2c_f32_bf16 v30, v46, v14
  v_dot2c_f32_bf16 v31, v50, v14
  v_dot2c_f32_bf16 v32, v54, v14
  v_dot2c_f32_bf16 v33, v58, v14
  v_dot2c_f32_bf16 v34, v62, v14
  v_dot2c_f32_bf16 v35, v66, v14
  v_dot2c_f32_bf16 v28, v39, v15
  v_dot2c_f32_bf16 v29, v43, v15
  v_dot2c_f32_bf16 v30, v47, v15
  v_dot2c_f32_bf16 v31, v51, v15
  v_dot2c_f32_bf16 v32, v55, v15
  v_dot2c_f32_bf16 v33, v59, v15
  v_dot2c_f32_bf16 v34, v63, v15
  v_dot2c_f32_bf16 v35, v67, v15
  buffer_load_dwordx4 v[36:39], v2, s[32:35], s48 offen nt
  buffer_load_dwordx4 v[40:43], v2, s[32:35], s49 offen nt
  buffer_load_dwordx4 v[44:47], v2, s[32:35], s50 offen nt
  buffer_load_dwordx4 v[48:51], v2, s[32:35], s51 offen nt
  buffer_load_dwordx4 v[52:55], v2, s[32:35], s52 offen nt
  buffer_load_dwordx4 v[56:59], v2, s[32:35], s53 offen nt
  buffer_load_dwordx4 v[60:63], v2, s[32:35], s54 offen nt
  buffer_load_dwordx4 v[64:67], v2, s[32:35], s55 offen nt
  v_add_f32_dpp v28, v28, v28 row_ror:8 row_mask:0xf bank_mask:0xf
  v_add_f32_dpp v29, v29, v29 row_ror:8 row_mask:0xf bank_mask:0xf
  v_add_f32_dpp v30, v30, v30 row_ror:8 row_mask:0xf bank_mask:0xf
  v_add_f32_dpp v31, v31, v31 row_ror:8 row_mask:0xf bank_mask:0xf
  v_add_f32_dpp v32, v32, v32 row_ror:8 row_mask:0xf bank_mask:0xf
  v_add_f32_dpp v33, v33, v33 row_ror:8 row_mask:0xf bank_mask:0xf
  v_add_f32_dpp v34, v34, v34 row_ror:8 row_mask:0xf bank_mask:0xf
  v_add_f32_dpp v35, v35, v35 row_ror:8 row_mask:0xf bank_mask:0xf
  v_add_f32_dpp v28, v28, v28 row_ror:4 row_mask:0xf bank_mask:0xf
  v_add_f32_dpp v29, v29, v29 row_ror:4 row_mask:0xf bank_mask:0xf
  v_add_f32_dpp v30, v30, v30 row_ror:4 row_mask:0xf bank_mask:0xf
  v_add_f32_dpp v31, v31, v31 row_ror:4 row_mask:0xf bank_mask:0xf
  v_add_f32_dpp v32, v32, v32 row_ror:4 row_mask:0xf bank_mask:0xf
  v_add_f32_dpp v33, v33, v33 row_ror:4 row_mask:0xf bank_mask:0xf
  v_add_f32_dpp v34, v34, v34 row_ror:4 row_mask:0xf bank_mask:0xf
  v_add_f32_dpp v35, v35, v35 row_ror:4 row_mask:0xf bank_mask:0xf
  v_add_f32_dpp v28, v28, v28 row_ror:2 row_mask:0xf bank_mask:0xf
  v_add_f32_dpp v29, v29, v29 row_ror:2 row_mask:0xf bank_mask:0xf
  v_add_f32_dpp v30, v30, v30 row_ror:2 row_mask:0xf bank_mask:0xf
  v_add_f32_dpp v31, v31, v31 row_ror:2 row_mask:0xf bank_mask:0xf
  v_add_f32_dpp v32, v32, v32 row_ror:2 row_mask:0xf bank_mask:0xf
  v_add_f32_dpp v33, v33, v33 row_ror:2 row_mask:0xf bank_mask:0xf
  v_add_f32_dpp v34, v34, v34 row_ror:2 row_mask:0xf bank_mask:0xf
  v_add_f32_dpp v35, v35, v35 row_ror:2 row_mask:0xf bank_mask:0xf
  v_add_f32_dpp v28, v28, v28 row_ror:1 row_mask:0xf bank_mask:0xf
  v_add_f32_dpp v29, v29, v29 row_ror:1 row_mask:0xf bank_mask:0xf
  v_add_f32_dpp v30, v30, v30 row_ror:1 row_mask:0xf bank_mask:0xf
  v_add_f32_dpp v31, v31, v31 row_ror:1 row_mask:0xf bank_mask:0xf
  v_add_f32_dpp v32, v32, v32 row_ror:1 row_mask:0xf bank_mask:0xf
  v_add_f32_dpp v33, v33, v33 row_ror:1 row_mask:0xf bank_mask:0xf
  v_add_f32_dpp v34, v34, v34 row_ror:1 row_mask:0xf bank_mask:0xf
  v_add_f32_dpp v35, v35, v35 row_ror:1 row_mask:0xf bank_mask:0xf
  v_fma_f32 v28, v28, v6, s56
  v_fma_f32 v29, v29, v6, s57
  v_fma_f32 v30, v30, v6, s58
  v_fma_f32 v31, v31, v6, s59
  v_fma_f32 v32, v32, v6, s60
  v_fma_f32 v33, v33, v6, s61
  v_fma_f32 v34, v34, v6, s62
  v_fma_f32 v35, v35, v6, s63
  v_max3_f32 v7, v4, v28, v29
  v_max3_f32 v7, v7, v30, v31
  v_max3_f32 v7, v7, v32, v33
  v_max3_f32 v7, v7, v34, v35
  v_sub_f32 v8, v4, v7
  v_sub_f32 v28, v28, v7
  v_sub_f32 v29, v29, v7
  v_sub_f32 v30, v30, v7
  v_sub_f32 v31, v31, v7
  v_sub_f32 v32, v32, v7
  v_sub_f32 v33, v33, v7
  v_sub_f32 v34, v34, v7
  v_sub_f32 v35, v35, v7
  v_exp_f32 v8, v8
  v_exp_f32 v28, v28
  v_exp_f32 v29, v29
  v_exp_f32 v30, v30
  v_exp_f32 v31, v31
  v_exp_f32 v32, v32
  v_exp_f32 v33, v33
  v_exp_f32 v34, v34
  v_exp_f32 v35, v35
  v_mov_b32 v4, v7
  v_mul_f32 v5, v5, v8
  v_mul_f32 v20, v20, v8
  v_mul_f32 v21, v21, v8
  v_mul_f32 v22, v22, v8
  v_mul_f32 v23, v23, v8
  v_mul_f32 v24, v24, v8
  v_mul_f32 v25, v25, v8
  v_mul_f32 v26, v26, v8
  v_mul_f32 v27, v27, v8
  v_add_f32 v5, v5, v28
  v_add_f32 v5, v5, v29
  v_add_f32 v5, v5, v30
  v_add_f32 v5, v5, v31
  v_add_f32 v5, v5, v32
  v_add_f32 v5, v5, v33
  v_add_f32 v5, v5, v34
  v_add_f32 v5, v5, v35
  s_waitcnt vmcnt(8)
  v_lshlrev_b32 v9, 16, v68
  v_and_b32 v10, s74, v68
  v_fmac_f32 v20, v9, v28
  v_fmac_f32 v21, v10, v28
  v_lshlrev_b32 v9, 16, v69
  v_and_b32 v10, s74, v69
  v_fmac_f32 v22, v9, v28
  v_fmac_f32 v23, v10, v28
  v_lshlrev_b32 v9, 16, v70
  v_and_b32 v10, s74, v70
  v_fmac_f32 v24, v9, v28
  v_fmac_f32 v25, v10, v28
  v_lshlrev_b32 v9, 16, v71
  v_and_b32 v10, s74, v71
  v_fmac_f32 v26, v9, v28
  v_fmac_f32 v27, v10, v28
  v_lshlrev_b32 v9, 16, v72
  v_and_b32 v10, s74, v72
  v_fmac_f32 v20, v9, v29
  v_fmac_f32 v21, v10, v29
  v_lshlrev_b32 v9, 16, v73
  v_and_b32 v10, s74, v73
  v_fmac_f32 v22, v9, v29
  v_fmac_f32 v23, v10, v29
  v_lshlrev_b32 v9, 16, v74
  v_and_b32 v10, s74, v74
  v_fmac_f32 v24, v9, v29
  v_fmac_f32 v25, v10, v29
  v_lshlrev_b32 v9, 16, v75
  v_and_b32 v10, s74, v75
  v_fmac_f32 v26, v9, v29
  v_fmac_f32 v27, v10, v29
  v_lshlrev_b32 v9, 16, v76
  v_and_b32 v10, s74, v76
  v_fmac_f32 v20, v9, v30
  v_fmac_f32 v21, v10, v30
  v_lshlrev_b32 v9, 16, v77
  v_and_b32 v10, s74, v77
  v_fmac_f32 v22, v9, v30
  v_fmac_f32 v23, v10, v30
  v_lshlrev_b32 v9, 16, v78
  v_and_b32 v10, s74, v78
  v_fmac_f32 v24, v9, v30
  v_fmac_f32 v25, v10, v30
  v_lshlrev_b32 v9, 16, v79
  v_and_b32 v10, s74, v79
  v_fmac_f32 v26, v9, v30
  v_fmac_f32 v27, v10, v30
  v_lshlrev_b32 v9, 16, v80
  v_and_b32 v10, s74, v80
  v_fmac_f32 v20, v9, v31
  v_fmac_f32 v21, v10, v31
  v_lshlrev_b32 v9, 16, v81
  v_and_b32 v10, s74, v81
  v_fmac_f32 v22, v9, v31
  v_fmac_f32 v23, v10, v31
  v_lshlrev_b32 v9, 16, v82
  v_and_b32 v10, s74, v82
  v_fmac_f32 v24, v9, v31
  v_fmac_f32 v25, v10, v31
  v_lshlrev_b32 v9, 16, v83
  v_and_b32 v10, s74, v83
  v_fmac_f32 v26, v9, v31
  v_fmac_f32 v27, v10, v31
  v_lshlrev_b32 v9, 16, v84
  v_and_b32 v10, s74, v84
  v_fmac_f32 v20, v9, v32
  v_fmac_f32 v21, v10, v32
  v_lshlrev_b32 v9, 16, v85
  v_and_b32 v10, s74, v85
  v_fmac_f32 v22, v9, v32
  v_fmac_f32 v23, v10, v32
  v_lshlrev_b32 v9, 16, v86
  v_and_b32 v10, s74, v86
  v_fmac_f32 v24, v9, v32
  v_fmac_f32 v25, v10, v32
  v_lshlrev_b32 v9, 16, v87
  v_and_b32 v10, s74, v87
  v_fmac_f32 v26, v9, v32
  v_fmac_f32 v27, v10, v32
  v_lshlrev_b32 v9, 16, v88
  v_and_b32 v10, s74, v88
  v_fmac_f32 v20, v9, v33
  v_fmac_f32 v21, v10, v33
  v_lshlrev_b32 v9, 16, v89
  v_and_b32 v10, s74, v89
  v_fmac_f32 v22, v9, v33
  v_fmac_f32 v23, v10, v33
  v_lshlrev_b32 v9, 16, v90
  v_and_b32 v10, s74, v90
  v_fmac_f32 v24, v9, v33
  v_fmac_f32 v25, v10, v33
  v_lshlrev_b32 v9, 16, v91
  v_and_b32 v10, s74, v91
  v_fmac_f32 v26, v9, v33
  v_fmac_f32 v27, v10, v33
  v_lshlrev_b32 v9, 16, v92
  v_and_b32 v10, s74, v92
  v_fmac_f32 v20, v9, v34
  v_fmac_f32 v21, v10, v34
  v_lshlrev_b32 v9, 16, v93
  v_and_b32 v10, s74, v93
  v_fmac_f32 v22, v9, v34
  v_fmac_f32 v23, v10, v34
  v_lshlrev_b32 v9, 16, v94
  v_and_b32 v10, s74, v94
  v_fmac_f32 v24, v9, v34
  v_fmac_f32 v25, v10, v34
  v_lshlrev_b32 v9, 16, v95
  v_and_b32 v10, s74, v95
  v_fmac_f32 v26, v9, v34
  v_fmac_f32 v27, v10, v34
  v_lshlrev_b32 v9, 16, v96
  v_and_b32 v10, s74, v96
  v_fmac_f32 v20, v9, v35
  v_fmac_f32 v21, v10, v35
  v_lshlrev_b32 v9, 16, v97
  v_and_b32 v10, s74, v97
  v_fmac_f32 v22, v9, v35
  v_fmac_f32 v23, v10, v35
  v_lshlrev_b32 v9, 16, v98
  v_and_b32 v10, s74, v98
  v_fmac_f32 v24, v9, v35
  v_fmac_f32 v25, v10, v35
  v_lshlrev_b32 v9, 16, v99
  v_and_b32 v10, s74, v99
  v_fmac_f32 v26, v9, v35
  v_fmac_f32 v27, v10, v35
  buffer_load_dwordx4 v[68:71], v2, s[36:39], s48 offen nt
  buffer_load_dwordx4 v[72:75], v2, s[36:39], s49 offen nt
  buffer_load_dwordx4 v[76:79], v2, s[36:39], s50 offen nt
  buffer_load_dwordx4 v[80:83], v2, s[36:39], s51 offen nt
  buffer_load_dwordx4 v[84:87], v2, s[36:39], s52 offen nt
  buffer_load_dwordx4 v[88:91], v2, s[36:39], s53 offen nt
  buffer_load_dwordx4 v[92:95], v2, s[36:39], s54 offen nt
  buffer_load_dwordx4 v[96:99], v2, s[36:39], s55 offen nt
  s_sub_i32 s72, s72, 8
  s_add_u32 s71, s71, 1
  s_cmp_lt_u32 s71, s70
  s_cbranch_scc1 L_loop
L_loop_done:
  s_waitcnt vmcnt(0)
  s_mul_i32 s75, s64, 2064
  v_lshl_add_u32 v9, v1, 5, s75
  ds_write_b128 v9, v[20:23] offset:4096
  ds_write_b128 v9, v[24:27] offset:4112
  v_lshrrev_b32 v10, 4, v0
  v_lshlrev_b32 v11, 3, v10
  ds_write_b64 v11, v[4:5] offset:37120
  v_and_b32 v8, 15, v0
  v_mul_u32_u24 v9, 2064, v8
  v_lshl_add_u32 v9, v10, 5, v9
  v_lshrrev_b32 v11, 8, v0
  v_lshl_add_u32 v6, v8, 2, v11
  v_lshlrev_b32 v6, 3, v6
  s_lshl_b32 s75, s2, 11
  v_lshl_add_u32 v12, v10, 5, s75
  s_lshl_b32 s75, s2, 6
  s_add_u32 s75, s75, 0x80000
  v_lshl_add_u32 v13, v11, 4, s75
  v_mov_b32 v30, s67
  v_mov_b32 v31, 0
  s_waitcnt lgkmcnt(0)
L_merge_bar:
  s_barrier
L_merge:
  ds_read_b64 v[4:5], v6 offset:37120
  ds_read_b128 v[20:23], v9 offset:4096
  ds_read_b128 v[24:27], v9 offset:4112
  s_waitcnt lgkmcnt(2)
  v_mov_b32 v28, v4
  s_nop 1
  v_max_f32_dpp v28, v28, v28 row_ror:8 row_mask:0xf bank_mask:0xf
  s_nop 1
  v_max_f32_dpp v28, v28, v28 row_ror:4 row_mask:0xf bank_mask:0xf
  s_nop 1
  v_max_f32_dpp v28, v28, v28 row_ror:2 row_mask:0xf bank_mask:0xf
  s_nop 1
  v_max_f32_dpp v28, v28, v28 row_ror:1 row_mask:0xf bank_mask:0xf
  v_sub_f32 v4, v4, v28
  v_exp_f32 v4, v4
  s_nop 0
  v_mul_f32 v29, v5, v4
  s_waitcnt lgkmcnt(0)
  v_mul_f32 v20, v20, v4
  v_mul_f32 v21, v21, v4
  v_mul_f32 v22, v22, v4
  v_mul_f32 v23, v23, v4
  v_mul_f32 v24, v24, v4
  v_mul_f32 v25, v25, v4
  v_mul_f32 v26, v26, v4
  v_mul_f32 v27, v27, v4
  v_add_f32_dpp v29, v29, v29 row_ror:8 row_mask:0xf bank_mask:0xf
  v_add_f32_dpp v20, v20, v20 row_ror:8 row_mask:0xf bank_mask:0xf
  v_add_f32_dpp v21, v21, v21 row_ror:8 row_mask:0xf bank_mask:0xf
  v_add_f32_dpp v22, v22, v22 row_ror:8 row_mask:0xf bank_mask:0xf
  v_add_f32_dpp v23, v23, v23 row_ror:8 row_mask:0xf bank_mask:0xf
  v_add_f32_dpp v24, v24, v24 row_ror:8 row_mask:0xf bank_mask:0xf
  v_add_f32_dpp v25, v25, v25 row_ror:8 row_mask:0xf bank_mask:0xf
  v_add_f32_dpp v26, v26, v26 row_ror:8 row_mask:0xf bank_mask:0xf
  v_add_f32_dpp v27, v27, v27 row_ror:8 row_mask:0xf bank_mask:0xf
  v_add_f32_dpp v29, v29, v29 row_ror:4 row_mask:0xf bank_mask:0xf
  v_add_f32_dpp v20, v20, v20 row_ror:4 row_mask:0xf bank_mask:0xf
  v_add_f32_dpp v21, v21, v21 row_ror:4 row_mask:0xf bank_mask:0xf
  v_add_f32_dpp v22, v22, v22 row_ror:4 row_mask:0xf bank_mask:0xf
  v_add_f32_dpp v23, v23, v23 row_ror:4 row_mask:0xf bank_mask:0xf
  v_add_f32_dpp v24, v24, v24 row_ror:4 row_mask:0xf bank_mask:0xf
  v_add_f32_dpp v25, v25, v25 row_ror:4 row_mask:0xf bank_mask:0xf
  v_add_f32_dpp v26, v26, v26 row_ror:4 row_mask:0xf bank_mask:0xf
  v_add_f32_dpp v27, v27, v27 row_ror:4 row_mask:0xf bank_mask:0xf
  v_add_f32_dpp v29, v29, v29 row_ror:2 row_mask:0xf bank_mask:0xf
  v_add_f32_dpp v20, v20, v20 row_ror:2 row_mask:0xf bank_mask:0xf
  v_add_f32_dpp v21, v21, v21 row_ror:2 row_mask:0xf bank_mask:0xf
  v_add_f32_dpp v22, v22, v22 row_ror:2 row_mask:0xf bank_mask:0xf
  v_add_f32_dpp v23, v23, v23 row_ror:2 row_mask:0xf bank_mask:0xf
  v_add_f32_dpp v24, v24, v24 row_ror:2 row_mask:0xf bank_mask:0xf
  v_add_f32_dpp v25, v25, v25 row_ror:2 row_mask:0xf bank_mask:0xf
  v_add_f32_dpp v26, v26, v26 row_ror:2 row_mask:0xf bank_mask:0xf
  v_add_f32_dpp v27, v27, v27 row_ror:2 row_mask:0xf bank_mask:0xf
  v_add_f32_dpp v29, v29, v29 row_ror:1 row_mask:0xf bank_mask:0xf
  v_add_f32_dpp v20, v20, v20 row_ror:1 row_mask:0xf bank_mask:0xf
  v_add_f32_dpp v21, v21, v21 row_ror:1 row_mask:0xf bank_mask:0xf
  v_add_f32_dpp v22, v22, v22 row_ror:1 row_mask:0xf bank_mask:0xf
  v_add_f32_dpp v23, v23, v23 row_ror:1 row_mask:0xf bank_mask:0xf
  v_add_f32_dpp v24, v24, v24 row_ror:1 row_mask:0xf bank_mask:0xf
  v_add_f32_dpp v25, v25, v25 row_ror:1 row_mask:0xf bank_mask:0xf
  v_add_f32_dpp v26, v26, v26 row_ror:1 row_mask:0xf bank_mask:0xf
  v_add_f32_dpp v27, v27, v27 row_ror:1 row_mask:0xf bank_mask:0xf
  v_cmp_eq_u32 vcc, 0, v8
  s_and_saveexec_b64 s[84:85], vcc
  global_store_dwordx4 v12, v[20:23], s[30:31]
  global_store_dwordx4 v12, v[24:27], s[30:31] offset:16
  v_and_b32 v9, 255, v0
  v_cmp_eq_u32 vcc, 0, v9
  s_and_b64 exec, exec, vcc
  s_cbranch_execz L_part_end
  global_store_dwordx4 v13, v[28:31], s[30:31]
L_part_end:
  s_endpgm
.globl pa_comb_kernel
.p2align 8
.type pa_comb_kernel,@function
pa_comb_kernel:
  s_cmp_ge_u32 s2, 256
  s_cbranch_scc1 L_comb_end
  s_load_dwordx2 s[8:9], s[0:1], 40
  s_load_dwordx2 s[12:13], s[0:1], 56
  s_lshr_b32 s20, s2, 2
  s_and_b32 s21, s2, 3
  s_lshr_b32 s3, s20, 5
  s_and_b32 s4, s20, 31
  s_lshr_b32 s5, s4, 2
  s_and_b32 s6, s4, 3
  v_and_b32 v1, 15, v0
  v_lshrrev_b32 v2, 4, v0
  s_lshl_b32 s7, s5, 11
  s_lshl_b32 s14, s6, 9
  s_add_u32 s7, s7, s14
  s_mul_i32 s14, s21, 128
  s_add_u32 s7, s7, s14
  v_lshl_add_u32 v3, v2, 4, s7
  v_lshl_add_u32 v3, v1, 14, v3
  s_lshl_b32 s14, s4, 4
  s_add_u32 s14, s14, 0x80000
  v_lshl_add_u32 v4, v1, 9, s14
  s_mov_b32 s22, 0x40000
  s_mov_b32 s23, 0x2000
  s_waitcnt lgkmcnt(0)
  s_mov_b32 s16, s12
  s_and_b32 s17, s13, 0xffff
  s_mov_b32 s18, 0x84000
  s_mov_b32 s19, 0x00020000
  buffer_load_dwordx3 v[8:10], v4, s[16:19], 0 offen
  buffer_load_dwordx3 v[12:14], v4, s[16:19], s23 offen
  buffer_load_dwordx4 v[16:19], v3, s[16:19], 0 offen
  buffer_load_dwordx4 v[20:23], v3, s[16:19], s22 offen
  s_lshl_b32 s7, s20, 8
  s_mul_i32 s14, s21, 64
  s_add_u32 s7, s7, s14
  v_lshl_add_u32 v5, v2, 3, s7
  v_mov_b32 v6, 0xf149f2ca
  s_waitcnt vmcnt(2)
  v_cmp_eq_u32 vcc, s3, v10
  v_cmp_eq_u32 s[24:25], s3, v14
  s_nop 1
  v_cndmask_b32 v8, v6, v8, vcc
  v_cndmask_b32 v12, v6, v12, s[24:25]
  v_max_f32 v7, v8, v12
  s_nop 1
  v_max_f32_dpp v7, v7, v7 row_ror:8 row_mask:0xf bank_mask:0xf
  s_nop 1
  v_max_f32_dpp v7, v7, v7 row_ror:4 row_mask:0xf bank_mask:0xf
  s_nop 1
  v_max_f32_dpp v7, v7, v7 row_ror:2 row_mask:0xf bank_mask:0xf
  s_nop 1
  v_max_f32_dpp v7, v7, v7 row_ror:1 row_mask:0xf bank_mask:0xf
  v_sub_f32 v8, v8, v7
  v_sub_f32 v12, v12, v7
  v_exp_f32 v8, v8
  v_exp_f32 v12, v12
  s_nop 0
  v_cndmask_b32 v8, 0, v8, vcc
  v_cndmask_b32 v12, 0, v12, s[24:25]
  v_cndmask_b32 v9, 0, v9, vcc
  v_cndmask_b32 v13, 0, v13, s[24:25]
  v_mul_f32 v24, v8, v9
  v_fmac_f32 v24, v12, v13
  s_waitcnt vmcnt(0)
  v_cndmask_b32 v16, 0, v16, vcc
  v_cndmask_b32 v20, 0, v20, s[24:25]
  v_cndmask_b32 v17, 0, v17, vcc
  v_cndmask_b32 v21, 0, v21, s[24:25]
  v_cndmask_b32 v18, 0, v18, vcc
  v_cndmask_b32 v22, 0, v22, s[24:25]
  v_cndmask_b32 v19, 0, v19, vcc
  v_cndmask_b32 v23, 0, v23, s[24:25]
  v_mul_f32 v25, v8, v16
  v_mul_f32 v26, v8, v17
  v_mul_f32 v27, v8, v18
  v_mul_f32 v28, v8, v19
  v_fmac_f32 v25, v12, v20
  v_fmac_f32 v26, v12, v21
  v_fmac_f32 v27, v12, v22
  v_fmac_f32 v28, v12, v23
  s_nop 1
  v_add_f32_dpp v24, v24, v24 row_ror:8 row_mask:0xf bank_mask:0xf
  v_add_f32_dpp v25, v25, v25 row_ror:8 row_mask:0xf bank_mask:0xf
  v_add_f32_dpp v26, v26, v26 row_ror:8 row_mask:0xf bank_mask:0xf
  v_add_f32_dpp v27, v27, v27 row_ror:8 row_mask:0xf bank_mask:0xf
  v_add_f32_dpp v28, v28, v28 row_ror:8 row_mask:0xf bank_mask:0xf
  v_add_f32_dpp v24, v24, v24 row_ror:4 row_mask:0xf bank_mask:0xf
  v_add_f32_dpp v25, v25, v25 row_ror:4 row_mask:0xf bank_mask:0xf
  v_add_f32_dpp v26, v26, v26 row_ror:4 row_mask:0xf bank_mask:0xf
  v_add_f32_dpp v27, v27, v27 row_ror:4 row_mask:0xf bank_mask:0xf
  v_add_f32_dpp v28, v28, v28 row_ror:4 row_mask:0xf bank_mask:0xf
  v_add_f32_dpp v24, v24, v24 row_ror:2 row_mask:0xf bank_mask:0xf
  v_add_f32_dpp v25, v25, v25 row_ror:2 row_mask:0xf bank_mask:0xf
  v_add_f32_dpp v26, v26, v26 row_ror:2 row_mask:0xf bank_mask:0xf
  v_add_f32_dpp v27, v27, v27 row_ror:2 row_mask:0xf bank_mask:0xf
  v_add_f32_dpp v28, v28, v28 row_ror:2 row_mask:0xf bank_mask:0xf
  v_add_f32_dpp v24, v24, v24 row_ror:1 row_mask:0xf bank_mask:0xf
  v_add_f32_dpp v25, v25, v25 row_ror:1 row_mask:0xf bank_mask:0xf
  v_add_f32_dpp v26, v26, v26 row_ror:1 row_mask:0xf bank_mask:0xf
  v_add_f32_dpp v27, v27, v27 row_ror:1 row_mask:0xf bank_mask:0xf
  v_add_f32_dpp v28, v28, v28 row_ror:1 row_mask:0xf bank_mask:0xf
  v_rcp_f32 v24, v24
  s_nop 0
  v_mul_f32 v25, v25, v24
  v_mul_f32 v26, v26, v24
  v_mul_f32 v27, v27, v24
  v_mul_f32 v28, v28, v24
  v_cvt_pk_bf16_f32 v30, v25, v26
  v_cvt_pk_bf16_f32 v31, v27, v28
  v_cmp_eq_u32 vcc, 0, v1
  s_and_saveexec_b64 s[26:27], vcc
  global_store_dwordx2 v5, v[30:31], s[8:9]
L_comb_end:
  s_endpgm
.section .rodata,"a"
.p2align 6
.amdhsa_kernel pa_part_kernel
  .amdhsa_next_free_vgpr 100
  .amdhsa_next_free_sgpr 100
  .amdhsa_accum_offset 100
  .amdhsa_group_segment_fixed_size 0
  .amdhsa_kernarg_size 64
  .amdhsa_user_sgpr_count 2
  .amdhsa_user_sgpr_kernarg_segment_ptr 1
  .amdhsa_system_sgpr_workgroup_id_x 1
.end_amdhsa_kernel
.p2align 6
.amdhsa_kernel pa_comb_kernel
  .amdhsa_next_free_vgpr 32
  .amdhsa_next_free_sgpr 100
  .amdhsa_accum_offset 32
  .amdhsa_group_segment_fixed_size 0
  .amdhsa_kernarg_size 64
  .amdhsa_user_sgpr_count 2
  .amdhsa_user_sgpr_kernarg_segment_ptr 1
  .amdhsa_system_sgpr_workgroup_id_x 1
.end_amdhsa_kernel
```
